```python
import torch

def _softmax(x, axis=-1):
    return torch.softmax(x, dim=axis)
def _gelu(x):
    return torch.nn.functional.gelu(x, approximate="tanh")
def _silu(x):
    return torch.nn.functional.silu(x)
def _sigmoid(x):
    return torch.sigmoid(x)
def _layernorm(x, axis=-1, eps=1e-5):
    m = x.mean(dim=axis, keepdim=True)
    v = x.var(dim=axis, keepdim=True, unbiased=False)
    return (x - m) / torch.sqrt(v + eps)
def _scatter_add(tgt, idx, src, axis=0):
    return tgt.clone().index_add_(axis, idx, src)
def _segment_sum(src, seg, n):
    out = torch.zeros((n,) + src.shape[1:], dtype=src.dtype)
    return out.index_add_(0, seg, src)
def _pad(x, pw):
    flat = tuple(v for pair in reversed(pw) for v in pair)
    return torch.nn.functional.pad(x, flat)

kernel_name = 'parallel_sum__gqa_block_cached__glu_gated_swiglu__decode'

def setup_inputs():

    _w = (lambda a: (lambda t: t.to(torch.bfloat16) if t.is_floating_point() else t)(torch.as_tensor(a)))
    def _A_setup():
        B, Sq, D = 1, 1, 640
        Hq, Hkv, Sk, Dh = 32, 32, 4096, 192
        assert Hq % Hkv == 0, (Hq, Hkv)
        return {
            "x": _w((lambda *s: torch.randn(*s, dtype=torch.bfloat16) * 0.05)(B, Sq, D)),
            "k_cache": _w((lambda *s: torch.randn(*s, dtype=torch.bfloat16) * 1.6)(B, Hkv, Sk, Dh)),
            "v_cache": _w((lambda *s: torch.randn(*s, dtype=torch.bfloat16) * 0.8)(B, Hkv, Sk, Dh)),
            "wq": _w((lambda *s: torch.randn(*s, dtype=torch.bfloat16) * 1.6)(D, Hq * Dh) * (D ** -0.5)),
            "wo": _w((lambda *s: torch.randn(*s, dtype=torch.bfloat16) * 0.8)(Hq * Dh, D) * ((Hq * Dh) ** -0.5)),
        }
    _A_in = _A_setup()

    def _B_setup():
        B, S, D, F = 1, 1, 640, 1536
        return {
            "x": _w((lambda *s: torch.randn(*s, dtype=torch.bfloat16) * 0.05)(B, S, D)),
            "w1": _w((lambda *s: torch.randn(*s, dtype=torch.bfloat16) * 0.4)(D, F) * (2.0 / D) ** 0.5),
            "w3": _w((lambda *s: torch.randn(*s, dtype=torch.bfloat16) * 0.4)(D, F) * (2.0 / D) ** 0.5),
            "w2": _w((lambda *s: torch.randn(*s, dtype=torch.bfloat16) * 0.4)(F, D) * (2.0 / F) ** 0.5),
        }
    _B_in = _B_setup()

    return {
        "A_x": _A_in["x"],
        "A_k_cache": _A_in["k_cache"],
        "A_v_cache": _A_in["v_cache"],
        "A_wq": _A_in["wq"],
        "A_wo": _A_in["wo"],
        "B_x": _B_in["x"],
        "B_w1": _B_in["w1"],
        "B_w3": _B_in["w3"],
        "B_w2": _B_in["w2"],
    }

def reference(A_x, A_k_cache, A_v_cache, A_wq, A_wo, B_x, B_w1, B_w3, B_w2):
    def _A_ref(x, k_cache, v_cache, wq, wo):
        B, Sq, D = x.shape
        Hq, Dh = 32, 192
        Hkv = k_cache.shape[1]
        rep = Hq // Hkv
        q = (lambda x, *d: x.permute(*d))((x @ wq).reshape(B, Sq, Hq, Dh), 0, 2, 1, 3)
        k = (lambda x, n, axis: torch.repeat_interleave(x, n, dim=axis))(k_cache, rep, axis=1)
        v = (lambda x, n, axis: torch.repeat_interleave(x, n, dim=axis))(v_cache, rep, axis=1)
        scores = torch.einsum("bhqd,bhkd->bhqk", q, k) * (Dh ** -0.5)
        p = _softmax(scores, axis=-1)
        o = torch.einsum("bhqk,bhkd->bhqd", p, v)
        return (lambda x, *d: x.permute(*d))(o, 0, 2, 1, 3).reshape(B, Sq, Hq * Dh) @ wo

    def _B_ref(x, w1, w3, w2):
        gate = torch.einsum("bsd,df->bsf", x, w1)
        up = torch.einsum("bsd,df->bsf", x, w3)
        h = _silu(gate) * up
        out = torch.einsum("bsf,fd->bsd", h, w2)
        return out

    x = A_x
    xn = _layernorm(x, axis=-1)
    return x + _A_ref(xn, A_k_cache, A_v_cache, A_wq, A_wo) + _B_ref(xn, B_w1, B_w3, B_w2)
```

```asm
; @launch grid=(256,1,1) block=(512,1,1) lds=11776
.amdgcn_target "amdgcn-amd-amdhsa--gfx950"
.text
.p2align 12
.globl parallel_sum__gqa_block_cached__glu_gated_swiglu__decode_kernel
.p2align 8
.type parallel_sum__gqa_block_cached__glu_gated_swiglu__decode_kernel,@function
parallel_sum__gqa_block_cached__glu_gated_swiglu__decode_kernel:
    s_load_dwordx16 s[4:19], s[0:1], 0
    s_load_dwordx8 s[20:27], s[0:1], 64
    s_cmpk_ge_u32 s2, 256
    s_cbranch_scc1 L_end
    v_lshrrev_b32 v1, 6, v0
    v_and_b32 v0, 63, v0
    v_readfirstlane_b32 s3, v1
    s_and_b32 s64, s2, 7
    s_lshr_b32 s71, s2, 3
    s_lshl_b32 s70, s64, 5
    s_add_u32 s65, s70, s71
    v_lshrrev_b32 v6, 3, v0
    v_and_b32 v7, 7, v0
    s_mov_b32 s43, 0x20000
    s_movk_i32 s30, 1280
    s_mov_b32 s31, s43
    v_mul_u32_u24 v9, 20, v0
    s_cmp_ge_u32 s3, 3
    s_cbranch_scc1 L_rf
    s_lshr_b32 s71, s65, 3
    s_mul_i32 s71, s71, 3
    s_add_u32 s69, s71, s3
    s_and_b32 s70, s65, 7
    s_mul_i32 s46, s70, 160
    s_mul_i32 s71, s70, 983040
    s_lshl_b32 s45, s69, 7
    s_add_u32 s45, s45, s71
    v_mul_u32_u24 v46, 122880, v6
    v_mul_u32_u24 v10, 20, v6
    s_movk_i32 s73, 12288
    s_mov_b32 s42, 7864320
    s_mov_b32 s44, 10
    s_lshl3_add_u32 s70, s69, s70
    s_lshl_b32 s70, s70, 8
    s_add_u32 s75, s70, 262144
    s_branch L_ra
L_rf:
    s_lshr_b32 s71, s2, 3
    s_add_u32 s71, s71, 26
    s_and_b32 s71, s71, 31
    s_mul_i32 s66, s71, 26
    s_lshr_b32 s66, s66, 8
    s_mul_i32 s70, s66, 10
    s_sub_u32 s67, s71, s70
    s_lshl2_add_u32 s70, s3, s66
    s_cmp_lg_u32 s70, 31
    s_cbranch_scc1 L_nopf
    s_getpc_b64 s[40:41]
L_pc:
    v_lshlrev_b32 v12, 7, v0
    v_min_u32 v12, L_done-L_pc, v12
    global_load_dword v13, v12, s[40:41]
L_nopf:
    s_cmp_eq_u32 s66, 3
    s_cselect_b32 s44, 0, 8
    s_cmp_ge_u32 s3, 5
    s_cselect_b32 s44, 0, s44
    s_mov_b32 s42, 1966080
    s_mul_i32 s69, s64, 3
    s_add_u32 s69, s69, s66
    s_mul_i32 s72, s67, 196608
    s_lshl_b32 s71, s69, 7
    s_add_u32 s45, s72, s71
    s_lshl_b32 s46, s67, 7
    v_mul_u32_u24 v46, 24576, v6
    v_lshlrev_b32 v10, 4, v6
    s_movk_i32 s73, 3072
    s_lshl1_add_u32 s70, s69, s3
    s_mul_i32 s70, s70, 10
    s_add_u32 s70, s70, s67
    s_lshl_b32 s70, s70, 8
    s_add_u32 s75, s70, 57856
L_ra:
    v_lshl_add_u32 v46, v7, 4, v46
    v_add_u32 v47, s73, v46
    v_add_u32 v48, s73, v47
    v_add_u32 v49, s73, v48
    v_add_u32 v50, s73, v49
    s_cmp_eq_u32 s3, 3
    s_waitcnt lgkmcnt(0)
    s_cselect_b64 s[40:41], s[16:17], s[10:11]
    s_cmp_eq_u32 s3, 4
    s_cselect_b64 s[40:41], s[18:19], s[40:41]
    s_mov_b64 s[28:29], s[4:5]
    s_cmp_eq_u32 s44, 0
    s_cbranch_scc1 L_a0
    buffer_load_dwordx4 v[160:163], v46, s[40:43], s45 offen nt
    buffer_load_dwordx4 v[164:167], v47, s[40:43], s45 offen nt
    buffer_load_dwordx4 v[168:171], v48, s[40:43], s45 offen nt
    buffer_load_dwordx4 v[172:175], v49, s[40:43], s45 offen nt
    buffer_load_dwordx4 v[176:179], v50, s[40:43], s45 offen nt
    buffer_load_dwordx4 v[24:27], v9, s[28:31], 0 offen
    buffer_load_dword v28, v9, s[28:31], 0 offen offset:16
    buffer_load_dwordx4 v[30:33], v10, s[28:31], s46 offen
    buffer_load_dword v34, v10, s[28:31], s46 offen offset:16
L_a0:
    s_load_dword s68, s[26:27], 0
    s_load_dwordx4 s[16:19], s[4:5], 0
    v_add_u32 v51, s73, v50
    v_add_u32 v52, s73, v51
    v_add_u32 v53, s73, v52
    v_add_u32 v54, s73, v53
    v_add_u32 v55, s73, v54
    s_barrier
    s_cbranch_scc1 L_adone
    s_cmp_eq_u32 s44, 8
    buffer_load_dwordx4 v[180:183], v51, s[40:43], s45 offen nt
    buffer_load_dwordx4 v[184:187], v52, s[40:43], s45 offen nt
    buffer_load_dwordx4 v[188:191], v53, s[40:43], s45 offen nt
    s_cbranch_scc1 L_adone
    buffer_load_dwordx4 v[192:195], v54, s[40:43], s45 offen nt
    buffer_load_dwordx4 v[196:199], v55, s[40:43], s45 offen nt
L_adone:
    s_lshr_b32 s71, s2, 3
    s_add_u32 s71, s71, 26
    s_and_b32 s71, s71, 31
    s_mul_i32 s66, s71, 26
    s_lshr_b32 s66, s66, 8
    s_mul_i32 s70, s66, 10
    s_sub_u32 s67, s71, s70
    v_lshlrev_b32 v11, 3, v0
    v_mov_b32 v14, 0
    v_mov_b32 v15, 0
    ds_write_b64 v11, v[14:15] offset:1536
    s_mov_b32 s0, s75
    s_lshl3_add_u32 s70, s65, s3
    s_mul_i32 s76, s70, 24576
    v_mul_u32_u24 v1, 384, v6
    v_lshl_add_u32 v1, v7, 4, v1
    s_add_u32 s77, s76, 6144
    s_add_u32 s78, s76, 12288
    s_add_u32 s79, s76, 18432
    s_mov_b32 s34, 50331648
    s_mov_b32 s35, s43
    s_mov_b64 s[38:39], s[34:35]
    s_cmp_eq_u32 s66, 3
    s_cselect_b32 s50, 0, 7864320
    s_cselect_b32 s54, 0, 1966080
    s_mov_b32 s51, s35
    s_mov_b32 s55, s35
    s_mov_b32 s62, 0x10000000
    s_mov_b32 s63, s35
    s_mov_b64 s[58:59], s[30:31]
    s_mov_b64 s[32:33], s[6:7]
    s_mov_b64 s[36:37], s[8:9]
    s_mov_b64 s[48:49], s[12:13]
    s_mov_b64 s[52:53], s[20:21]
    s_mov_b64 s[56:57], s[22:23]
    s_mov_b64 s[60:61], s[26:27]
    s_mov_b32 s74, 0x0c0c0400
    s_mov_b32 s75, 0xffffff00
    s_lshr_b32 s70, s65, 3
    s_mul_i32 s70, s70, 3
    s_add_u32 s70, s70, s3
    s_lshl_b32 s70, s70, 11
    s_add_u32 s70, s70, 251904
    s_lshl_b32 s71, s67, 8
    s_sub_u32 s71, s0, s71
    s_cmp_eq_u32 s44, 8
    s_cselect_b32 s47, 10, 0
    s_cmp_ge_u32 s3, 5
    s_cselect_b32 s47, 8, s47
    s_cselect_b32 s1, s70, s71
    v_and_b32 v14, 1, v7
    v_lshlrev_b32 v14, 4, v14
    v_mov_b32 v15, 0xffff
    v_lshlrev_b32 v14, v14, v15
    v_lshrrev_b32 v15, 1, v7
    v_cmp_eq_u32 vcc, 0, v15
    s_nop 1
    v_cndmask_b32 v2, 0, v14, vcc
    v_cmp_eq_u32 vcc, 1, v15
    s_nop 1
    v_cndmask_b32 v3, 0, v14, vcc
    v_cmp_eq_u32 vcc, 2, v15
    s_nop 1
    v_cndmask_b32 v4, 0, v14, vcc
    v_cmp_eq_u32 vcc, 3, v15
    s_nop 1
    v_cndmask_b32 v5, 0, v14, vcc
    v_and_b32 v62, 31, v0
    s_lshl_b32 s70, s64, 7
    v_lshl_add_u32 v62, v62, 2, s70
    v_bfe_u32 v9, v0, 4, 1
    v_lshl_add_u32 v9, v9, 3, v7
    v_lshlrev_b32 v9, 4, v9
    v_and_b32 v11, 0x28, v0
    v_mov_b32 v14, 0x40000000
    v_cmp_eq_u32 vcc, 0, v11
    s_nop 1
    v_cndmask_b32 v9, v14, v9, vcc
    s_cmp_eq_u32 s44, 0
    s_cselect_b32 s70, 0x40000000, 0
    v_or_b32 v9, s70, v9
    s_cmp_eq_u32 s47, 0
    s_cselect_b32 s70, 0x40000000, 0
    v_lshl_or_b32 v10, v0, 4, s70
    s_cmp_eq_u32 s47, 10
    s_cselect_b32 s70, 32, 0
    v_cmp_gt_u32 vcc, s70, v0
    s_nop 1
    v_cndmask_b32 v60, v14, v10, vcc
    v_cndmask_b32 v61, 0, -1, vcc
    s_mov_b32 s73, 1
    s_mov_b32 s70, 0x9e3779b1
    s_waitcnt lgkmcnt(0)
    s_mul_i32 s16, s16, s70
    s_xor_b32 s16, s16, s17
    s_mul_i32 s16, s16, s70
    s_xor_b32 s16, s16, s18
    s_mul_i32 s16, s16, s70
    s_xor_b32 s16, s16, s19
    s_mul_i32 s16, s16, s70
    s_and_b32 s16, s16, s75
    s_add_u32 s68, s68, s70
    s_add_u32 s68, s68, s16
    s_cmp_lg_u32 s3, 5
    s_cbranch_scc1 L_nomark
    s_getreg_b32 s70, hwreg(HW_REG_XCC_ID, 0, 4)
    s_add_u32 s70, s70, s68
    s_and_b32 s20, s65, 1
    s_mul_i32 s20, s20, 10
    s_and_b32 s21, s65, 4
    s_add_u32 s20, s20, s21
    s_bfe_u32 s21, s65, 0x10001
    s_add_u32 s20, s20, s21
    s_lshl_b32 s20, s20, 12
    s_and_b32 s21, s65, 0xf8
    s_lshl4_add_u32 s20, s21, s20
    s_add_u32 s20, s20, 851968
    s_xor_b32 s21, s20, 0x2000
    s_load_dword s22, s[60:61], s21
    s_load_dword s23, s[60:61], s20
    s_waitcnt lgkmcnt(1)
    s_nop 1
    s_getreg_b32 s20, hwreg(HW_REG_IB_STS, 8, 4)
    s_cmp_eq_u32 s20, 0
    s_cselect_b32 s20, 16, 0
    s_add_u32 s70, s70, s20
    s_lshl_b32 s71, s65, 2
    v_mov_b32 v14, s70
    v_mov_b32 v15, 0
    s_mov_b64 exec, 1
    buffer_store_dword v14, v15, s[60:63], s71 offen offset:2048
    s_mov_b64 exec, -1
L_nomark:
    s_waitcnt vmcnt(5)
    s_barrier
    buffer_load_dwordx4 v[64:67], v1, s[32:35], s76 offen offset:0 nt
    s_barrier
    buffer_load_dwordx4 v[68:71], v1, s[32:35], s76 offen offset:128 nt
    s_barrier
    buffer_load_dwordx4 v[72:75], v1, s[32:35], s76 offen offset:256 nt
    s_waitcnt vmcnt(2)
    buffer_load_dwordx4 v[76:79], v1, s[32:35], s76 offen offset:3072 nt
    s_cmp_eq_u32 s44, 0
    s_cbranch_scc1 L_sk1
    v_lshlrev_b32 v36, 16, v24
    v_and_b32 v37, 0xffff0000, v24
    v_lshlrev_b32 v38, 16, v25
    v_and_b32 v39, 0xffff0000, v25
    v_lshlrev_b32 v40, 16, v26
    v_and_b32 v41, 0xffff0000, v26
    v_lshlrev_b32 v42, 16, v27
    v_and_b32 v43, 0xffff0000, v27
    v_lshlrev_b32 v44, 16, v28
    v_and_b32 v45, 0xffff0000, v28
    v_add_f32 v11, v36, v37
    v_add_f32 v11, v11, v38
    v_add_f32 v11, v11, v39
    v_add_f32 v11, v11, v40
    v_add_f32 v11, v11, v41
    v_add_f32 v11, v11, v42
    v_add_f32 v11, v11, v43
    v_add_f32 v11, v11, v44
    v_add_f32 v11, v11, v45
    s_nop 1
    v_add_f32_dpp v11, v11, v11 quad_perm:[1,0,3,2] row_mask:0xf bank_mask:0xf
    s_nop 1
    v_add_f32_dpp v11, v11, v11 quad_perm:[2,3,0,1] row_mask:0xf bank_mask:0xf
    s_nop 1
    v_add_f32_dpp v11, v11, v11 row_half_mirror row_mask:0xf bank_mask:0xf
    s_nop 1
    v_add_f32_dpp v11, v11, v11 row_mirror row_mask:0xf bank_mask:0xf
    v_mov_b32 v14, v11
    s_nop 1
    v_permlane16_swap_b32 v11, v14
    v_add_f32 v11, v11, v14
    v_mov_b32 v14, v11
    s_nop 1
    v_permlane32_swap_b32 v11, v14
    v_add_f32 v11, v11, v14
    v_mul_f32 v15, 0x3acccccd, v11
    v_sub_f32 v36, v36, v15
    v_sub_f32 v37, v37, v15
    v_sub_f32 v38, v38, v15
    v_sub_f32 v39, v39, v15
    v_sub_f32 v40, v40, v15
    v_sub_f32 v41, v41, v15
    v_sub_f32 v42, v42, v15
    v_sub_f32 v43, v43, v15
    v_sub_f32 v44, v44, v15
    v_sub_f32 v45, v45, v15
    v_mul_f32 v11, v36, v36
    v_fmac_f32 v11, v37, v37
L_sk1:
    s_waitcnt vmcnt(2)
    buffer_load_dwordx4 v[80:83], v1, s[32:35], s76 offen offset:3200 nt
    s_cmp_eq_u32 s44, 0
    s_cbranch_scc1 L_sk2
    v_fmac_f32 v11, v38, v38
    v_fmac_f32 v11, v39, v39
    v_fmac_f32 v11, v40, v40
    v_fmac_f32 v11, v41, v41
    v_fmac_f32 v11, v42, v42
    v_fmac_f32 v11, v43, v43
    v_fmac_f32 v11, v44, v44
    v_fmac_f32 v11, v45, v45
    s_nop 1
    v_add_f32_dpp v11, v11, v11 quad_perm:[1,0,3,2] row_mask:0xf bank_mask:0xf
    s_nop 1
    v_add_f32_dpp v11, v11, v11 quad_perm:[2,3,0,1] row_mask:0xf bank_mask:0xf
    s_nop 1
    v_add_f32_dpp v11, v11, v11 row_half_mirror row_mask:0xf bank_mask:0xf
    s_nop 1
    v_add_f32_dpp v11, v11, v11 row_mirror row_mask:0xf bank_mask:0xf
    v_mov_b32 v14, v11
    s_nop 1
    v_permlane16_swap_b32 v11, v14
    v_add_f32 v11, v11, v14
    v_mov_b32 v14, v11
    s_nop 1
    v_permlane32_swap_b32 v11, v14
    v_add_f32 v11, v11, v14
    v_mul_f32 v16, 0x3acccccd, v11
    v_cvt_pk_bf16_f32 v14, v15, v16
    v_lshlrev_b32 v15, 16, v14
    v_and_b32 v16, 0xffff0000, v14
    v_add_f32 v16, 0x3727c5ac, v16
    v_cvt_pk_bf16_f32 v16, v16, v16
    v_lshlrev_b32 v16, 16, v16
    v_sqrt_f32 v16, v16
    s_nop 0
    v_cvt_pk_bf16_f32 v16, v16, v16
    v_lshlrev_b32 v16, 16, v16
    v_rcp_f32 v16, v16
    v_lshlrev_b32 v36, 16, v30
    v_and_b32 v37, 0xffff0000, v30
    v_lshlrev_b32 v38, 16, v31
    v_and_b32 v39, 0xffff0000, v31
    v_lshlrev_b32 v40, 16, v32
    v_and_b32 v41, 0xffff0000, v32
    v_lshlrev_b32 v42, 16, v33
    v_and_b32 v43, 0xffff0000, v33
    v_lshlrev_b32 v44, 16, v34
    v_and_b32 v45, 0xffff0000, v34
    v_sub_f32 v36, v36, v15
    v_sub_f32 v37, v37, v15
    v_sub_f32 v38, v38, v15
L_sk2:
    s_waitcnt vmcnt(2)
    buffer_load_dwordx4 v[84:87], v1, s[32:35], s76 offen offset:3328 nt
    s_cmp_eq_u32 s44, 0
    s_cbranch_scc1 L_sk3
    v_sub_f32 v39, v39, v15
    v_sub_f32 v40, v40, v15
    v_sub_f32 v41, v41, v15
    v_sub_f32 v42, v42, v15
    v_sub_f32 v43, v43, v15
    v_sub_f32 v44, v44, v15
    v_sub_f32 v45, v45, v15
    v_cvt_pk_bf16_f32 v30, v36, v37
    v_cvt_pk_bf16_f32 v31, v38, v39
    v_cvt_pk_bf16_f32 v32, v40, v41
    v_cvt_pk_bf16_f32 v33, v42, v43
    v_cvt_pk_bf16_f32 v34, v44, v45
    v_lshlrev_b32 v36, 16, v30
    v_and_b32 v37, 0xffff0000, v30
    v_lshlrev_b32 v38, 16, v31
    v_and_b32 v39, 0xffff0000, v31
    v_lshlrev_b32 v40, 16, v32
    v_and_b32 v41, 0xffff0000, v32
    v_lshlrev_b32 v42, 16, v33
    v_and_b32 v43, 0xffff0000, v33
    v_lshlrev_b32 v44, 16, v34
    v_and_b32 v45, 0xffff0000, v34
    v_mul_f32 v36, v36, v16
    v_mul_f32 v37, v37, v16
    v_mul_f32 v38, v38, v16
    v_mul_f32 v39, v39, v16
    v_mul_f32 v40, v40, v16
    v_mul_f32 v41, v41, v16
    v_mul_f32 v42, v42, v16
    v_mul_f32 v43, v43, v16
    v_mul_f32 v44, v44, v16
    v_mul_f32 v45, v45, v16
    v_cvt_pk_bf16_f32 v36, v36, v36
    v_cvt_pk_bf16_f32 v37, v37, v37
    v_cvt_pk_bf16_f32 v38, v38, v38
    v_cvt_pk_bf16_f32 v39, v39, v39
    v_cvt_pk_bf16_f32 v40, v40, v40
    v_cvt_pk_bf16_f32 v41, v41, v41
    v_cvt_pk_bf16_f32 v42, v42, v42
    v_cvt_pk_bf16_f32 v43, v43, v43
    v_cvt_pk_bf16_f32 v44, v44, v44
    v_cvt_pk_bf16_f32 v45, v45, v45
L_sk3:
    s_waitcnt vmcnt(2)
    buffer_load_dwordx4 v[88:91], v1, s[32:35], s77 offen offset:0 nt
    s_cmp_eq_u32 s44, 0
    s_cbranch_scc1 L_sk4
    v_and_b32 v200, v36, v2
    v_and_b32 v201, v36, v3
    v_and_b32 v202, v36, v4
    v_and_b32 v203, v36, v5
    v_and_b32 v204, v37, v2
    v_and_b32 v205, v37, v3
    v_and_b32 v206, v37, v4
    v_and_b32 v207, v37, v5
    v_and_b32 v208, v38, v2
    v_and_b32 v209, v38, v3
    v_and_b32 v210, v38, v4
    v_and_b32 v211, v38, v5
    v_and_b32 v212, v39, v2
    v_and_b32 v213, v39, v3
    v_and_b32 v214, v39, v4
    v_and_b32 v215, v39, v5
    v_and_b32 v216, v40, v2
    v_and_b32 v217, v40, v3
    v_and_b32 v218, v40, v4
    v_and_b32 v219, v40, v5
    v_and_b32 v220, v41, v2
    v_and_b32 v221, v41, v3
    v_and_b32 v222, v41, v4
    v_and_b32 v223, v41, v5
    v_and_b32 v224, v42, v2
    v_and_b32 v225, v42, v3
    v_and_b32 v226, v42, v4
    v_and_b32 v227, v42, v5
    v_and_b32 v228, v43, v2
    v_and_b32 v229, v43, v3
    v_and_b32 v230, v43, v4
    v_and_b32 v231, v43, v5
    v_and_b32 v232, v44, v2
    v_and_b32 v233, v44, v3
    v_and_b32 v234, v44, v4
    v_and_b32 v235, v44, v5
    v_and_b32 v236, v45, v2
    v_and_b32 v237, v45, v3
    v_and_b32 v238, v45, v4
    v_and_b32 v239, v45, v5
L_sk4:
    s_waitcnt vmcnt(7)
    s_cmp_eq_u32 s44, 0
    s_cbranch_scc1 L_nomm
    v_mfma_f32_16x16x32_bf16 v[56:59], v[200:203], v[160:163], 0
    v_mfma_f32_16x16x32_bf16 v[56:59], v[204:207], v[164:167], v[56:59]
    v_mfma_f32_16x16x32_bf16 v[56:59], v[208:211], v[168:171], v[56:59]
    v_mfma_f32_16x16x32_bf16 v[56:59], v[212:215], v[172:175], v[56:59]
    v_mfma_f32_16x16x32_bf16 v[56:59], v[216:219], v[176:179], v[56:59]
    v_mfma_f32_16x16x32_bf16 v[56:59], v[220:223], v[180:183], v[56:59]
    v_mfma_f32_16x16x32_bf16 v[56:59], v[224:227], v[184:187], v[56:59]
    v_mfma_f32_16x16x32_bf16 v[56:59], v[228:231], v[188:191], v[56:59]
    s_cmp_eq_u32 s44, 8
    s_cbranch_scc1 L_mdone
    v_mfma_f32_16x16x32_bf16 v[56:59], v[232:235], v[192:195], v[56:59]
    v_mfma_f32_16x16x32_bf16 v[56:59], v[236:239], v[196:199], v[56:59]
L_mdone:
    s_nop 7
    v_permlane32_swap_b32 v56, v24
    v_permlane32_swap_b32 v57, v25
    v_permlane32_swap_b32 v58, v26
    v_permlane32_swap_b32 v59, v27
    v_add_f32_dpp v56, v24, v56 row_ror:8 row_mask:0xf bank_mask:0xf
    v_add_f32_dpp v57, v25, v57 row_ror:8 row_mask:0xf bank_mask:0xf
    v_add_f32_dpp v58, v26, v58 row_ror:8 row_mask:0xf bank_mask:0xf
    v_add_f32_dpp v59, v27, v59 row_ror:8 row_mask:0xf bank_mask:0xf
    v_add_u32 v56, 0x80, v56
    v_add_u32 v57, 0x80, v57
    v_add_u32 v58, 0x80, v58
    v_add_u32 v59, 0x80, v59
    v_mov_b32_sdwa v56, s68 dst_sel:BYTE_0 dst_unused:UNUSED_PRESERVE src0_sel:BYTE_0
    v_mov_b32_sdwa v57, s68 dst_sel:BYTE_0 dst_unused:UNUSED_PRESERVE src0_sel:BYTE_1
    v_mov_b32_sdwa v58, s68 dst_sel:BYTE_0 dst_unused:UNUSED_PRESERVE src0_sel:BYTE_2
    v_mov_b32_sdwa v59, s68 dst_sel:BYTE_0 dst_unused:UNUSED_PRESERVE src0_sel:BYTE_3
L_nomm:
    buffer_load_dword v63, v62, s[60:63], 0 offen offset:2048 sc1
    s_waitcnt vmcnt(3)
    buffer_load_dwordx4 v[92:95], v1, s[32:35], s77 offen offset:128 nt
    s_waitcnt vmcnt(3)
    buffer_load_dwordx4 v[96:99], v1, s[32:35], s77 offen offset:256 nt
    s_waitcnt vmcnt(3)
    buffer_load_dwordx4 v[100:103], v1, s[32:35], s77 offen offset:3072 nt
    s_waitcnt vmcnt(3)
    s_getreg_b32 s73, hwreg(HW_REG_XCC_ID, 0, 4)
    s_add_u32 s73, s73, s68
    v_subrev_u32 v63, s73, v63
    v_and_b32 v63, 0xffffffef, v63
    v_cmp_ne_u32 vcc, 0, v63
    s_nop 0
    s_or_b32 s73, vcc_lo, vcc_hi
    s_cmp_eq_u32 s73, 0
    s_cbranch_scc0 L_ps5
    buffer_store_dwordx4 v[56:59], v9, s[60:63], s0 offen
L_pe6:
    v_and_b32 v61, s68, v61
    s_waitcnt vmcnt(3)
    buffer_load_dwordx4 v[104:107], v1, s[32:35], s77 offen offset:3200 nt
    s_waitcnt vmcnt(3)
    buffer_load_dwordx4 v[108:111], v1, s[32:35], s77 offen offset:3328 nt
    s_waitcnt vmcnt(3)
    buffer_load_dwordx4 v[112:115], v1, s[32:35], s78 offen offset:0 nt
    s_waitcnt vmcnt(2)
    buffer_load_dwordx4 v[116:119], v1, s[32:35], s78 offen offset:128 nt
    s_waitcnt vmcnt(2)
    buffer_load_dwordx4 v[120:123], v1, s[32:35], s78 offen offset:256 nt
    s_waitcnt vmcnt(2)
    buffer_load_dwordx4 v[124:127], v1, s[32:35], s78 offen offset:3072 nt
    buffer_load_dwordx4 v[240:243], v10, s[60:63], s1 offen offset:0 sc1
    buffer_load_dwordx4 v[244:247], v10, s[60:63], s1 offen offset:1024 sc1
    buffer_load_dwordx4 v[248:251], v60, s[60:63], s1 offen offset:2048 sc1
    buffer_load_dword v63, v62, s[60:63], 0 offen offset:2048 sc1
    s_waitcnt vmcnt(6)
    buffer_load_dwordx4 v[128:131], v1, s[32:35], s78 offen offset:3200 nt
    s_waitcnt vmcnt(6)
    buffer_load_dwordx4 v[132:135], v1, s[32:35], s78 offen offset:3328 nt
    s_waitcnt vmcnt(6)
    buffer_load_dwordx4 v[136:139], v1, s[32:35], s79 offen offset:0 nt
    s_waitcnt vmcnt(3)
    s_cmp_eq_u32 s47, 0
    s_cbranch_scc1 L_gnone
    s_mov_b32 s69, 2000000
L_gchk:
    v_perm_b32 v12, v241, v240, s74
    v_perm_b32 v11, v243, v242, s74
    v_lshl_or_b32 v12, v11, 16, v12
    v_perm_b32 v13, v245, v244, s74
    v_perm_b32 v11, v247, v246, s74
    v_lshl_or_b32 v13, v11, 16, v13
    v_perm_b32 v14, v249, v248, s74
    v_perm_b32 v11, v251, v250, s74
    v_lshl_or_b32 v14, v11, 16, v14
    v_xor_b32 v12, s68, v12
    v_xor_b32 v13, s68, v13
    v_xor_b32 v14, v61, v14
    v_or3_b32 v12, v12, v13, v14
    v_cmp_ne_u32 vcc, 0, v12
    s_cbranch_vccnz L_gretry
L_gok:
    v_and_b32 v240, s75, v240
    v_and_b32 v241, s75, v241
    v_and_b32 v242, s75, v242
    v_and_b32 v243, s75, v243
    v_and_b32 v244, s75, v244
    v_and_b32 v245, s75, v245
    v_and_b32 v246, s75, v246
    v_and_b32 v247, s75, v247
    v_and_b32 v248, s75, v248
    v_and_b32 v249, s75, v249
    v_and_b32 v250, s75, v250
    v_and_b32 v251, s75, v251
    v_add_f32 v240, v240, v244
    v_add_f32 v241, v241, v245
    v_add_f32 v242, v242, v246
    v_add_f32 v243, v243, v247
    v_add_f32 v240, v240, v248
    v_add_f32 v241, v241, v249
    v_add_f32 v242, v242, v250
    v_add_f32 v243, v243, v251
    v_mov_b32 v244, v240
    v_mov_b32 v245, v241
    v_mov_b32 v246, v242
    v_mov_b32 v247, v243
    v_permlane16_swap_b32 v240, v244
    v_permlane16_swap_b32 v241, v245
    v_permlane16_swap_b32 v242, v246
    v_permlane16_swap_b32 v243, v247
    v_add_f32 v240, v240, v244
    v_add_f32 v241, v241, v245
    v_add_f32 v242, v242, v246
    v_add_f32 v243, v243, v247
    v_mov_b32 v244, v240
    v_mov_b32 v245, v241
    v_mov_b32 v246, v242
    v_mov_b32 v247, v243
    v_permlane32_swap_b32 v240, v244
    v_permlane32_swap_b32 v241, v245
    v_permlane32_swap_b32 v242, v246
    v_permlane32_swap_b32 v243, v247
    v_add_f32 v240, v240, v244
    v_add_f32 v241, v241, v245
    v_add_f32 v242, v242, v246
    v_add_f32 v243, v243, v247
    v_and_b32 v11, 8, v0
    v_lshlrev_b32 v11, 1, v11
    v_lshl_add_u32 v11, v7, 5, v11
    s_sub_u32 s70, s3, 3
    s_lshl_b32 s70, s70, 8
    v_add_u32 v11, s70, v11
    ds_write_b128 v11, v[240:243] offset:0
L_gnone:
    s_getreg_b32 s73, hwreg(HW_REG_XCC_ID, 0, 4)
    s_add_u32 s73, s73, s68
    v_subrev_u32 v63, s73, v63
    v_cmp_eq_u32 s[24:25], 16, v63
    v_and_b32 v63, 0xffffffef, v63
    v_cmp_ne_u32 vcc, 0, v63
    s_nop 0
    s_or_b32 s73, vcc_lo, vcc_hi
    s_cmp_eq_u32 s73, 0
    s_cselect_b32 s71, 2, 1
    s_lshl_b32 s70, s3, 2
    v_mov_b32 v11, s70
    v_mov_b32 v12, s71
    ds_write_b32 v11, v12 offset:1792
    s_waitcnt vmcnt(2)
    buffer_load_dwordx4 v[140:143], v1, s[32:35], s79 offen offset:128 nt
    s_waitcnt vmcnt(2)
    buffer_load_dwordx4 v[144:147], v1, s[32:35], s79 offen offset:256 nt
    v_lshlrev_b32 v13, 2, v7
    s_mov_b32 s69, 20000000
    v_lshlrev_b32 v8, 5, v7
    s_lshl_b32 s70, s3, 5
    v_lshl_add_u32 v9, v6, 2, s70
L_h1:
    ds_read_b32 v12, v13 offset:1792
    ds_read_b128 v[232:235], v8 offset:512
    ds_read_b128 v[236:239], v8 offset:528
    ds_read_b128 v[240:243], v8 offset:768
    ds_read_b128 v[244:247], v8 offset:784
    ds_read_b128 v[248:251], v8 offset:1024
    ds_read_b128 v[252:255], v8 offset:1040
    ds_read2st64_b32 v[10:11], v9 offset0:0 offset1:1
    s_waitcnt lgkmcnt(0)
    v_cmp_eq_u32 vcc, 0, v12
    s_cbranch_vccz L_h1ok
    s_sub_u32 s69, s69, 1
    s_cbranch_scc0 L_h1
L_h1ok:
    v_cmp_eq_u32 vcc, 2, v12
    s_nop 0
    s_cmp_eq_u32 vcc_lo, 0
    s_cselect_b32 s73, 1, 0
    s_waitcnt vmcnt(2)
    buffer_load_dwordx4 v[148:151], v1, s[32:35], s79 offen offset:3072 nt
    s_add_u32 s70, s66, 2
    s_cmp_ge_u32 s70, 3
    s_cselect_b32 s71, 3, 0
    s_sub_u32 s70, s70, s71
    s_mul_i32 s71, s64, 3
    s_add_u32 s72, s71, s70
    s_lshl3_add_u32 s42, s72, s3
    s_lshl_b32 s42, s42, 10
    s_add_u32 s42, s42, 262144
    s_lshr_b32 s69, s3, 1
    s_lshl2_add_u32 s72, s72, s69
    s_lshl_b32 s72, s72, 6
    s_and_b32 s69, s3, 1
    s_add_u32 s72, s72, s69
    s_mul_i32 s72, s72, 1280
    s_lshl_b32 s69, s67, 7
    s_add_u32 s40, s72, s69
    s_add_u32 s47, s40, 20480
    s_add_u32 s71, s71, s66
    s_lshl3_add_u32 s72, s71, s3
    s_mul_i32 s72, s72, 10240
    s_add_u32 s41, s72, s69
    s_lshl_b32 s71, s71, 7
    s_lshl_b32 s72, s67, 15
    s_add_u32 s72, s72, s71
    s_add_u32 s45, s72, 524288
    s_lshr_b32 s70, s65, 3
    s_lshl_b32 s43, s70, 7
    s_add_u32 s43, s43, 4096
    s_mul_i32 s70, s70, 6
    s_add_u32 s70, s70, s3
    s_lshl_b32 s70, s70, 10
    s_and_b32 s71, s65, 7
    s_lshl4_add_u32 s70, s71, s70
    s_add_u32 s44, s70, 262144
    v_cvt_pk_bf16_f32 v24, v232, v233
    v_cvt_pk_bf16_f32 v25, v234, v235
    v_cvt_pk_bf16_f32 v26, v236, v237
    v_cvt_pk_bf16_f32 v27, v238, v239
    v_cvt_pk_bf16_f32 v28, v240, v241
    v_cvt_pk_bf16_f32 v29, v242, v243
    v_cvt_pk_bf16_f32 v30, v244, v245
    v_cvt_pk_bf16_f32 v31, v246, v247
    v_cvt_pk_bf16_f32 v32, v248, v249
    v_cvt_pk_bf16_f32 v33, v250, v251
    v_cvt_pk_bf16_f32 v34, v252, v253
    v_cvt_pk_bf16_f32 v35, v254, v255
    v_cvt_pk_bf16_f32 v12, v10, v11
    v_lshlrev_b32 v10, 16, v12
    v_and_b32 v11, 0xffff0000, v12
    v_mul_f32 v12, 0xbfb8aa3b, v10
    v_exp_f32 v12, v12
    s_nop 0
    v_add_f32 v12, 1.0, v12
    v_rcp_f32 v12, v12
    s_nop 0
    v_mul_f32 v10, v10, v12
    v_cvt_pk_bf16_f32 v10, v10, v10
    v_lshlrev_b32 v10, 16, v10
    v_mul_f32 v10, v10, v11
    v_cvt_pk_bf16_f32 v10, v10, v10
    v_and_b32 v56, v10, v2
    v_and_b32 v57, v10, v3
    v_and_b32 v58, v10, v4
    v_and_b32 v59, v10, v5
    v_and_b32 v9, 1, v6
    v_and_b32 v10, 6, v6
    v_lshl_add_u32 v9, v9, 5, v10
    v_lshlrev_b32 v8, 4, v7
    v_mul_u32_u24 v62, 1280, v9
    v_add_u32 v62, v62, v8
    v_mul_u32_u24 v63, 1280, v6
    v_add_u32 v63, v63, v8
    s_waitcnt vmcnt(2)
    buffer_load_dwordx4 v[152:155], v1, s[32:35], s79 offen offset:3200 nt
    s_waitcnt vmcnt(22)
    v_mov_b32 v36, 0
    v_mov_b32 v37, 0
    v_dot2c_f32_bf16 v36, v64, v24
    v_dot2c_f32_bf16 v37, v76, v24
    v_dot2c_f32_bf16 v36, v65, v25
    v_dot2c_f32_bf16 v37, v77, v25
    v_dot2c_f32_bf16 v36, v66, v26
    v_dot2c_f32_bf16 v37, v78, v26
    v_dot2c_f32_bf16 v36, v67, v27
    v_dot2c_f32_bf16 v37, v79, v27
    v_dot2c_f32_bf16 v36, v68, v28
    v_dot2c_f32_bf16 v37, v80, v28
    v_dot2c_f32_bf16 v36, v69, v29
    v_dot2c_f32_bf16 v37, v81, v29
    v_dot2c_f32_bf16 v36, v70, v30
    v_dot2c_f32_bf16 v37, v82, v30
    v_dot2c_f32_bf16 v36, v71, v31
    v_dot2c_f32_bf16 v37, v83, v31
    v_dot2c_f32_bf16 v36, v72, v32
    v_dot2c_f32_bf16 v37, v84, v32
    v_dot2c_f32_bf16 v36, v73, v33
    v_dot2c_f32_bf16 v37, v85, v33
    v_dot2c_f32_bf16 v36, v74, v34
    v_dot2c_f32_bf16 v37, v86, v34
    v_dot2c_f32_bf16 v36, v75, v35
    v_dot2c_f32_bf16 v37, v87, v35
    s_waitcnt vmcnt(2)
    buffer_load_dwordx4 v[156:159], v1, s[32:35], s79 offen offset:3328 nt
    s_waitcnt vmcnt(16)
    v_mov_b32 v38, 0
    v_mov_b32 v39, 0
    v_dot2c_f32_bf16 v38, v88, v24
    v_dot2c_f32_bf16 v39, v100, v24
    v_dot2c_f32_bf16 v38, v89, v25
    v_dot2c_f32_bf16 v39, v101, v25
    v_dot2c_f32_bf16 v38, v90, v26
    v_dot2c_f32_bf16 v39, v102, v26
    v_dot2c_f32_bf16 v38, v91, v27
    v_dot2c_f32_bf16 v39, v103, v27
    v_dot2c_f32_bf16 v38, v92, v28
    v_dot2c_f32_bf16 v39, v104, v28
    v_dot2c_f32_bf16 v38, v93, v29
    v_dot2c_f32_bf16 v39, v105, v29
    v_dot2c_f32_bf16 v38, v94, v30
    v_dot2c_f32_bf16 v39, v106, v30
    v_dot2c_f32_bf16 v38, v95, v31
    v_dot2c_f32_bf16 v39, v107, v31
    v_dot2c_f32_bf16 v38, v96, v32
    v_dot2c_f32_bf16 v39, v108, v32
    v_dot2c_f32_bf16 v38, v97, v33
    v_dot2c_f32_bf16 v39, v109, v33
    v_dot2c_f32_bf16 v38, v98, v34
    v_dot2c_f32_bf16 v39, v110, v34
    v_dot2c_f32_bf16 v38, v99, v35
    v_dot2c_f32_bf16 v39, v111, v35
    s_waitcnt vmcnt(2)
    buffer_load_dwordx4 v[160:163], v1, s[36:39], s76 offen offset:0 nt
    s_waitcnt vmcnt(7)
    v_mov_b32 v40, 0
    v_mov_b32 v41, 0
    v_dot2c_f32_bf16 v40, v112, v24
    v_dot2c_f32_bf16 v41, v124, v24
    v_dot2c_f32_bf16 v40, v113, v25
    v_dot2c_f32_bf16 v41, v125, v25
    v_dot2c_f32_bf16 v40, v114, v26
    v_dot2c_f32_bf16 v41, v126, v26
    v_dot2c_f32_bf16 v40, v115, v27
    v_dot2c_f32_bf16 v41, v127, v27
    v_dot2c_f32_bf16 v40, v116, v28
    v_dot2c_f32_bf16 v41, v128, v28
    v_dot2c_f32_bf16 v40, v117, v29
    v_dot2c_f32_bf16 v41, v129, v29
    v_dot2c_f32_bf16 v40, v118, v30
    v_dot2c_f32_bf16 v41, v130, v30
    v_dot2c_f32_bf16 v40, v119, v31
    v_dot2c_f32_bf16 v41, v131, v31
    v_dot2c_f32_bf16 v40, v120, v32
    v_dot2c_f32_bf16 v41, v132, v32
    v_dot2c_f32_bf16 v40, v121, v33
    v_dot2c_f32_bf16 v41, v133, v33
    v_dot2c_f32_bf16 v40, v122, v34
    v_dot2c_f32_bf16 v41, v134, v34
    v_dot2c_f32_bf16 v40, v123, v35
    v_dot2c_f32_bf16 v41, v135, v35
    s_waitcnt vmcnt(2)
    buffer_load_dwordx4 v[164:167], v1, s[36:39], s76 offen offset:128 nt
    s_waitcnt vmcnt(2)
    buffer_load_dwordx4 v[168:171], v1, s[36:39], s76 offen offset:256 nt
    s_waitcnt vmcnt(3)
    v_mov_b32 v42, 0
    v_mov_b32 v43, 0
    v_dot2c_f32_bf16 v42, v136, v24
    v_dot2c_f32_bf16 v43, v148, v24
    v_dot2c_f32_bf16 v42, v137, v25
    v_dot2c_f32_bf16 v43, v149, v25
    v_dot2c_f32_bf16 v42, v138, v26
    v_dot2c_f32_bf16 v43, v150, v26
    v_dot2c_f32_bf16 v42, v139, v27
    v_dot2c_f32_bf16 v43, v151, v27
    v_dot2c_f32_bf16 v42, v140, v28
    v_dot2c_f32_bf16 v43, v152, v28
    v_dot2c_f32_bf16 v42, v141, v29
    v_dot2c_f32_bf16 v43, v153, v29
    v_dot2c_f32_bf16 v42, v142, v30
    v_dot2c_f32_bf16 v43, v154, v30
    v_dot2c_f32_bf16 v42, v143, v31
    v_dot2c_f32_bf16 v43, v155, v31
    v_dot2c_f32_bf16 v42, v144, v32
    v_dot2c_f32_bf16 v43, v156, v32
    v_dot2c_f32_bf16 v42, v145, v33
    v_dot2c_f32_bf16 v43, v157, v33
    v_dot2c_f32_bf16 v42, v146, v34
    v_dot2c_f32_bf16 v43, v158, v34
    v_dot2c_f32_bf16 v42, v147, v35
    v_dot2c_f32_bf16 v43, v159, v35
    s_waitcnt vmcnt(2)
    buffer_load_dwordx4 v[172:175], v1, s[36:39], s76 offen offset:3072 nt
    v_add_f32_dpp v36, v36, v36 quad_perm:[1,0,3,2] row_mask:0xf bank_mask:0xf
    v_add_f32_dpp v37, v37, v37 quad_perm:[1,0,3,2] row_mask:0xf bank_mask:0xf
    v_add_f32_dpp v38, v38, v38 quad_perm:[1,0,3,2] row_mask:0xf bank_mask:0xf
    v_add_f32_dpp v39, v39, v39 quad_perm:[1,0,3,2] row_mask:0xf bank_mask:0xf
    v_add_f32_dpp v40, v40, v40 quad_perm:[1,0,3,2] row_mask:0xf bank_mask:0xf
    v_add_f32_dpp v41, v41, v41 quad_perm:[1,0,3,2] row_mask:0xf bank_mask:0xf
    v_add_f32_dpp v42, v42, v42 quad_perm:[1,0,3,2] row_mask:0xf bank_mask:0xf
    v_add_f32_dpp v43, v43, v43 quad_perm:[1,0,3,2] row_mask:0xf bank_mask:0xf
    v_add_f32_dpp v36, v36, v36 quad_perm:[2,3,0,1] row_mask:0xf bank_mask:0xf
    v_add_f32_dpp v37, v37, v37 quad_perm:[2,3,0,1] row_mask:0xf bank_mask:0xf
    v_add_f32_dpp v38, v38, v38 quad_perm:[2,3,0,1] row_mask:0xf bank_mask:0xf
    v_add_f32_dpp v39, v39, v39 quad_perm:[2,3,0,1] row_mask:0xf bank_mask:0xf
    v_add_f32_dpp v40, v40, v40 quad_perm:[2,3,0,1] row_mask:0xf bank_mask:0xf
    v_add_f32_dpp v41, v41, v41 quad_perm:[2,3,0,1] row_mask:0xf bank_mask:0xf
    v_add_f32_dpp v42, v42, v42 quad_perm:[2,3,0,1] row_mask:0xf bank_mask:0xf
    v_add_f32_dpp v43, v43, v43 quad_perm:[2,3,0,1] row_mask:0xf bank_mask:0xf
    v_add_f32_dpp v36, v36, v36 row_half_mirror row_mask:0xf bank_mask:0xf
    v_add_f32_dpp v37, v37, v37 row_half_mirror row_mask:0xf bank_mask:0xf
    v_add_f32_dpp v38, v38, v38 row_half_mirror row_mask:0xf bank_mask:0xf
    v_add_f32_dpp v39, v39, v39 row_half_mirror row_mask:0xf bank_mask:0xf
    v_add_f32_dpp v40, v40, v40 row_half_mirror row_mask:0xf bank_mask:0xf
    v_add_f32_dpp v41, v41, v41 row_half_mirror row_mask:0xf bank_mask:0xf
    v_add_f32_dpp v42, v42, v42 row_half_mirror row_mask:0xf bank_mask:0xf
    v_add_f32_dpp v43, v43, v43 row_half_mirror row_mask:0xf bank_mask:0xf
    v_cvt_pk_bf16_f32 v8, v36, v37
    v_cvt_pk_bf16_f32 v9, v38, v39
    v_cvt_pk_bf16_f32 v10, v40, v41
    v_cvt_pk_bf16_f32 v11, v42, v43
    s_waitcnt vmcnt(2)
    buffer_load_dwordx4 v[176:179], v1, s[36:39], s76 offen offset:3200 nt
    v_lshlrev_b32 v36, 16, v8
    v_and_b32 v37, 0xffff0000, v8
    v_lshlrev_b32 v38, 16, v9
    v_and_b32 v39, 0xffff0000, v9
    v_lshlrev_b32 v40, 16, v10
    v_and_b32 v41, 0xffff0000, v10
    v_lshlrev_b32 v42, 16, v11
    v_and_b32 v43, 0xffff0000, v11
    s_mov_b32 s70, 0x3d93cd3a
    v_mul_f32 v36, s70, v36
    v_mul_f32 v37, s70, v37
    v_mul_f32 v38, s70, v38
    v_mul_f32 v39, s70, v39
    v_mul_f32 v40, s70, v40
    v_mul_f32 v41, s70, v41
    v_mul_f32 v42, s70, v42
    v_mul_f32 v43, s70, v43
    v_cvt_pk_bf16_f32 v8, v36, v37
    v_cvt_pk_bf16_f32 v9, v38, v39
    v_cvt_pk_bf16_f32 v10, v40, v41
    v_cvt_pk_bf16_f32 v11, v42, v43
    v_lshlrev_b32 v36, 16, v8
    v_and_b32 v37, 0xffff0000, v8
    v_lshlrev_b32 v38, 16, v9
    v_and_b32 v39, 0xffff0000, v9
    v_lshlrev_b32 v40, 16, v10
    v_and_b32 v41, 0xffff0000, v10
    v_lshlrev_b32 v42, 16, v11
    s_waitcnt vmcnt(2)
    buffer_load_dwordx4 v[180:183], v1, s[36:39], s76 offen offset:3328 nt
    v_and_b32 v43, 0xffff0000, v11
    s_mov_b32 s70, 0x3fb8aa3b
    v_mul_f32 v36, s70, v36
    v_mul_f32 v37, s70, v37
    v_mul_f32 v38, s70, v38
    v_mul_f32 v39, s70, v39
    v_mul_f32 v40, s70, v40
    v_mul_f32 v41, s70, v41
    v_mul_f32 v42, s70, v42
    v_mul_f32 v43, s70, v43
    v_max3_f32 v12, v36, v37, v38
    v_max3_f32 v8, v39, v40, v41
    v_max3_f32 v12, v12, v42, v43
    v_max_f32 v12, v12, v8
    s_nop 1
    v_max_f32_dpp v12, v12, v12 row_ror:8 row_mask:0xf bank_mask:0xf
    v_mov_b32 v8, v12
    s_nop 1
    v_permlane16_swap_b32 v12, v8
    v_max_f32 v12, v12, v8
    v_mov_b32 v8, v12
    s_nop 1
    v_permlane32_swap_b32 v12, v8
    v_max_f32 v12, v12, v8
    v_sub_f32 v36, v36, v12
    v_sub_f32 v37, v37, v12
    v_sub_f32 v38, v38, v12
    v_sub_f32 v39, v39, v12
    v_sub_f32 v40, v40, v12
    v_sub_f32 v41, v41, v12
    v_sub_f32 v42, v42, v12
    s_waitcnt vmcnt(2)
    buffer_load_dwordx4 v[184:187], v1, s[36:39], s77 offen offset:0 nt
    v_sub_f32 v43, v43, v12
    v_exp_f32 v36, v36
    v_exp_f32 v37, v37
    v_exp_f32 v38, v38
    v_exp_f32 v39, v39
    v_exp_f32 v40, v40
    v_exp_f32 v41, v41
    v_exp_f32 v42, v42
    v_exp_f32 v43, v43
    v_add_f32 v13, v36, v37
    v_add_f32 v13, v13, v38
    v_add_f32 v13, v13, v39
    v_add_f32 v13, v13, v40
    v_add_f32 v13, v13, v41
    v_add_f32 v13, v13, v42
    v_add_f32 v13, v13, v43
    s_nop 1
    v_add_f32_dpp v13, v13, v13 row_ror:8 row_mask:0xf bank_mask:0xf
    v_mov_b32 v8, v13
    s_nop 1
    v_permlane16_swap_b32 v13, v8
    v_add_f32 v13, v13, v8
    v_mov_b32 v8, v13
    s_nop 1
    v_permlane32_swap_b32 v13, v8
    v_add_f32 v13, v13, v8
    s_lshl_b32 s70, s3, 4
    v_mov_b32 v8, s70
    v_mov_b32 v14, 1
    ds_write_b96 v8, v[12:14] offset:1536
    s_waitcnt vmcnt(2)
    buffer_load_dwordx4 v[188:191], v1, s[36:39], s77 offen offset:128 nt
    v_cvt_pk_bf16_f32 v36, v36, v36
    v_cvt_pk_bf16_f32 v37, v37, v37
    v_cvt_pk_bf16_f32 v38, v38, v38
    v_cvt_pk_bf16_f32 v39, v39, v39
    v_cvt_pk_bf16_f32 v40, v40, v40
    v_cvt_pk_bf16_f32 v41, v41, v41
    v_cvt_pk_bf16_f32 v42, v42, v42
    v_cvt_pk_bf16_f32 v43, v43, v43
    v_and_b32 v96, v36, v2
    v_and_b32 v97, v36, v3
    v_and_b32 v98, v36, v4
    v_and_b32 v99, v36, v5
    v_and_b32 v100, v37, v2
    v_and_b32 v101, v37, v3
    v_and_b32 v102, v37, v4
    v_and_b32 v103, v37, v5
    v_and_b32 v104, v38, v2
    v_and_b32 v105, v38, v3
    v_and_b32 v106, v38, v4
    v_and_b32 v107, v38, v5
    v_and_b32 v108, v39, v2
    v_and_b32 v109, v39, v3
    v_and_b32 v110, v39, v4
    s_waitcnt vmcnt(2)
    buffer_load_dwordx4 v[192:195], v1, s[36:39], s77 offen offset:256 nt
    v_and_b32 v111, v39, v5
    v_and_b32 v112, v40, v2
    v_and_b32 v113, v40, v3
    v_and_b32 v114, v40, v4
    v_and_b32 v115, v40, v5
    v_and_b32 v116, v41, v2
    v_and_b32 v117, v41, v3
    v_and_b32 v118, v41, v4
    v_and_b32 v119, v41, v5
    v_and_b32 v120, v42, v2
    v_and_b32 v121, v42, v3
    v_and_b32 v122, v42, v4
    v_and_b32 v123, v42, v5
    v_and_b32 v124, v43, v2
    v_and_b32 v125, v43, v3
    v_and_b32 v126, v43, v4
    v_and_b32 v127, v43, v5
    v_add_u32 v136, 10240, v62
    v_lshlrev_b32 v28, 4, v7
    s_mul_i32 s70, s3, 832
    v_lshl_add_u32 v24, v0, 2, s70
    s_lshl_b32 s71, s3, 7
    v_lshl_add_u32 v9, v6, 4, s71
    s_waitcnt vmcnt(2)
    buffer_load_dwordx4 v[196:199], v1, s[36:39], s77 offen offset:3072 nt
    v_mul_u32_u24 v25, 832, v7
    v_add_u32 v25, v25, v9
    v_lshlrev_b32 v27, 4, v0
    v_mov_b32 v8, 0x40000000
    v_cmp_eq_u32 vcc, 0, v7
    v_lshlrev_b32 v26, 7, v6
    s_nop 0
    v_cndmask_b32 v26, v8, v26, vcc
    s_mul_i32 s70, s3, 384
    v_lshl_add_u32 v29, v0, 2, s70
    v_bfe_u32 v9, v0, 2, 2
    v_lshrrev_b32 v10, 4, v0
    v_and_b32 v11, 3, v0
    v_lshlrev_b32 v11, 4, v11
    v_mul_u32_u24 v30, 384, v9
    v_lshl_add_u32 v30, v10, 6, v30
    v_add_u32 v30, v30, v11
    v_cmp_gt_u32 vcc, 2, v9
    v_and_b32 v31, 2, v10
    v_add_u32 v31, v31, v10
    v_lshl_add_u32 v31, v9, 1, v31
    v_lshl_add_u32 v31, v31, 12, v11
    v_cndmask_b32 v31, v8, v31, vcc
    s_lshl_b32 s70, s65, 4
    s_add_u32 s70, s70, 4096
    v_mov_b32 v9, 0x40000000
    s_cmp_lg_u32 s3, 1
    s_cbranch_scc1 L_nost
    s_mov_b32 s69, 20000000
    v_mov_b32 v18, s68
    v_mov_b32 v9, 0
L_h2:
    ds_read_b96 v[20:22], v28 offset:1536
    s_waitcnt lgkmcnt(0)
    v_cmp_eq_u32 vcc, 0, v22
    s_cbranch_vccz L_h2ok
    s_sub_u32 s69, s69, 1
    s_cbranch_scc0 L_h2
L_h2ok:
    v_mov_b32 v16, v20
    s_nop 1
    v_max_f32_dpp v16, v16, v16 quad_perm:[1,0,3,2] row_mask:0xf bank_mask:0xf
    s_nop 1
    v_max_f32_dpp v16, v16, v16 quad_perm:[2,3,0,1] row_mask:0xf bank_mask:0xf
    s_nop 1
    v_max_f32_dpp v16, v16, v16 row_half_mirror row_mask:0xf bank_mask:0xf
    v_sub_f32 v20, v20, v16
    v_exp_f32 v20, v20
    s_nop 0
    v_mul_f32 v17, v20, v21
    s_nop 1
    v_add_f32_dpp v17, v17, v17 quad_perm:[1,0,3,2] row_mask:0xf bank_mask:0xf
    s_nop 1
    v_add_f32_dpp v17, v17, v17 quad_perm:[2,3,0,1] row_mask:0xf bank_mask:0xf
    s_nop 1
    v_add_f32_dpp v17, v17, v17 row_half_mirror row_mask:0xf bank_mask:0xf
L_nost:
    s_mov_b64 exec, 1
    s_cmp_eq_u32 s73, 0
    s_cbranch_scc0 L_ps14
    buffer_store_dwordx3 v[16:18], v9, s[60:63], s70 offen
L_pe15:
    s_mov_b64 exec, -1
    s_waitcnt vmcnt(7)
    v_mfma_f32_16x16x32_bf16 v[44:47], v[96:99], v[160:163], 0
    v_mfma_f32_16x16x32_bf16 v[48:51], v[96:99], v[164:167], 0
    v_mfma_f32_16x16x32_bf16 v[52:55], v[96:99], v[168:171], 0
    s_waitcnt vmcnt(4)
    v_mfma_f32_16x16x32_bf16 v[44:47], v[100:103], v[172:175], v[44:47]
    v_mfma_f32_16x16x32_bf16 v[48:51], v[100:103], v[176:179], v[48:51]
    v_mfma_f32_16x16x32_bf16 v[52:55], v[100:103], v[180:183], v[52:55]
    s_waitcnt vmcnt(3)
    buffer_load_dwordx4 v[200:203], v1, s[36:39], s77 offen offset:3200 nt
    s_waitcnt vmcnt(3)
    buffer_load_dwordx4 v[204:207], v1, s[36:39], s77 offen offset:3328 nt
    s_waitcnt vmcnt(3)
    buffer_load_dwordx4 v[208:211], v1, s[36:39], s78 offen offset:0 nt
    v_mfma_f32_16x16x32_bf16 v[44:47], v[104:107], v[184:187], v[44:47]
    v_mfma_f32_16x16x32_bf16 v[48:51], v[104:107], v[188:191], v[48:51]
    v_mfma_f32_16x16x32_bf16 v[52:55], v[104:107], v[192:195], v[52:55]
    s_waitcnt vmcnt(2)
    buffer_load_dwordx4 v[212:215], v1, s[36:39], s78 offen offset:128 nt
    s_waitcnt vmcnt(2)
    buffer_load_dwordx4 v[216:219], v1, s[36:39], s78 offen offset:256 nt
    v_mfma_f32_16x16x32_bf16 v[44:47], v[108:111], v[196:199], v[44:47]
    v_mfma_f32_16x16x32_bf16 v[48:51], v[108:111], v[200:203], v[48:51]
    v_mfma_f32_16x16x32_bf16 v[52:55], v[108:111], v[204:207], v[52:55]
    s_waitcnt vmcnt(2)
    buffer_load_dwordx4 v[220:223], v1, s[36:39], s78 offen offset:3072 nt
    s_waitcnt vmcnt(2)
    buffer_load_dwordx4 v[224:227], v1, s[36:39], s78 offen offset:3200 nt
    s_waitcnt vmcnt(2)
    buffer_load_dwordx4 v[228:231], v1, s[36:39], s78 offen offset:3328 nt
    v_mfma_f32_16x16x32_bf16 v[44:47], v[112:115], v[208:211], v[44:47]
    v_mfma_f32_16x16x32_bf16 v[48:51], v[112:115], v[212:215], v[48:51]
    v_mfma_f32_16x16x32_bf16 v[52:55], v[112:115], v[216:219], v[52:55]
    s_waitcnt vmcnt(2)
    buffer_load_dwordx4 v[232:235], v1, s[36:39], s79 offen offset:0 nt
    buffer_load_dwordx3 v[32:34], v28, s[60:63], s43 offen sc1
    s_waitcnt vmcnt(3)
    buffer_load_dwordx4 v[236:239], v1, s[36:39], s79 offen offset:128 nt
    s_waitcnt vmcnt(3)
    buffer_load_dwordx4 v[240:243], v1, s[36:39], s79 offen offset:256 nt
    v_mfma_f32_16x16x32_bf16 v[44:47], v[116:119], v[220:223], v[44:47]
    v_mfma_f32_16x16x32_bf16 v[48:51], v[116:119], v[224:227], v[48:51]
    v_mfma_f32_16x16x32_bf16 v[52:55], v[116:119], v[228:231], v[52:55]
    s_waitcnt vmcnt(3)
    buffer_load_dwordx4 v[244:247], v1, s[36:39], s79 offen offset:3072 nt
    s_waitcnt vmcnt(3)
    s_mov_b32 s69, 2000000
L_stchk:
    v_cmp_ne_u32 vcc, s68, v34
    s_cbranch_vccnz L_stretry
L_stok:
    v_mov_b32 v8, v32
    s_nop 1
    v_max_f32_dpp v8, v8, v8 quad_perm:[1,0,3,2] row_mask:0xf bank_mask:0xf
    s_nop 1
    v_max_f32_dpp v8, v8, v8 quad_perm:[2,3,0,1] row_mask:0xf bank_mask:0xf
    s_nop 1
    v_max_f32_dpp v8, v8, v8 row_half_mirror row_mask:0xf bank_mask:0xf
    v_sub_f32 v32, v32, v8
    v_sub_f32 v60, v12, v8
    v_exp_f32 v32, v32
    v_exp_f32 v60, v60
    v_mul_f32 v33, v33, v32
    s_nop 1
    v_add_f32_dpp v33, v33, v33 quad_perm:[1,0,3,2] row_mask:0xf bank_mask:0xf
    s_nop 1
    v_add_f32_dpp v33, v33, v33 quad_perm:[2,3,0,1] row_mask:0xf bank_mask:0xf
    s_nop 1
    v_add_f32_dpp v33, v33, v33 row_half_mirror row_mask:0xf bank_mask:0xf
    v_rcp_f32 v33, v33
    s_nop 0
    v_mul_f32 v60, v60, v33
    s_add_u32 s68, s68, 0x3c6ef38f
    s_waitcnt vmcnt(2)
    buffer_load_dwordx4 v[248:251], v1, s[36:39], s79 offen offset:3200 nt
    s_waitcnt vmcnt(2)
    buffer_load_dwordx4 v[252:255], v1, s[36:39], s79 offen offset:3328 nt
    v_mfma_f32_16x16x32_bf16 v[44:47], v[120:123], v[232:235], v[44:47]
    v_mfma_f32_16x16x32_bf16 v[48:51], v[120:123], v[236:239], v[48:51]
    v_mfma_f32_16x16x32_bf16 v[52:55], v[120:123], v[240:243], v[52:55]
    s_waitcnt vmcnt(2)
    buffer_load_dwordx4 v[80:83], v63, s[52:55], s41 offen nt
    s_waitcnt vmcnt(2)
    buffer_load_dwordx4 v[64:67], v62, s[48:51], s40 offen nt
    s_waitcnt vmcnt(2)
    buffer_load_dwordx4 v[68:71], v136, s[48:51], s40 offen nt
    buffer_load_dwordx4 v[72:75], v62, s[48:51], s47 offen nt
    v_mfma_f32_16x16x32_bf16 v[44:47], v[124:127], v[244:247], v[44:47]
    v_mfma_f32_16x16x32_bf16 v[48:51], v[124:127], v[248:251], v[48:51]
    v_mfma_f32_16x16x32_bf16 v[52:55], v[124:127], v[252:255], v[52:55]
    s_nop 5
    v_permlane32_swap_b32 v44, v45
    v_permlane32_swap_b32 v46, v47
    v_permlane32_swap_b32 v48, v49
    v_permlane32_swap_b32 v50, v51
    v_permlane32_swap_b32 v52, v53
    v_permlane32_swap_b32 v54, v55
    v_add_f32_dpp v8, v45, v44 row_ror:8 row_mask:0xf bank_mask:0x3
    v_add_f32_dpp v9, v49, v48 row_ror:8 row_mask:0xf bank_mask:0x3
    v_add_f32_dpp v10, v53, v52 row_ror:8 row_mask:0xf bank_mask:0x3
    v_add_f32_dpp v8, v46, v47 row_ror:8 row_mask:0xf bank_mask:0xc
    v_add_f32_dpp v9, v50, v51 row_ror:8 row_mask:0xf bank_mask:0xc
    v_add_f32_dpp v10, v54, v55 row_ror:8 row_mask:0xf bank_mask:0xc
    v_mul_f32 v8, v8, v60
    v_mul_f32 v9, v9, v60
    v_mul_f32 v10, v10, v60
    ds_write2st64_b32 v24, v8, v9 offset0:8 offset1:9
    ds_write_b32 v24, v10 offset:2560
    buffer_load_dwordx4 v[76:79], v136, s[48:51], s47 offen nt
    s_cmp_ge_u32 s3, 6
    s_waitcnt lgkmcnt(0)
    s_barrier
    s_cbranch_scc1 L_nopub
    ds_read_b128 v[12:15], v25 offset:2048
    s_waitcnt lgkmcnt(0)
    v_add_f32_dpp v12, v12, v12 quad_perm:[1,0,3,2] row_mask:0xf bank_mask:0xf
    v_add_f32_dpp v13, v13, v13 quad_perm:[1,0,3,2] row_mask:0xf bank_mask:0xf
    v_add_f32_dpp v14, v14, v14 quad_perm:[1,0,3,2] row_mask:0xf bank_mask:0xf
    v_add_f32_dpp v15, v15, v15 quad_perm:[1,0,3,2] row_mask:0xf bank_mask:0xf
    v_add_f32_dpp v12, v12, v12 quad_perm:[2,3,0,1] row_mask:0xf bank_mask:0xf
    v_add_f32_dpp v13, v13, v13 quad_perm:[2,3,0,1] row_mask:0xf bank_mask:0xf
    v_add_f32_dpp v14, v14, v14 quad_perm:[2,3,0,1] row_mask:0xf bank_mask:0xf
    v_add_f32_dpp v15, v15, v15 quad_perm:[2,3,0,1] row_mask:0xf bank_mask:0xf
    v_add_f32_dpp v12, v12, v12 row_half_mirror row_mask:0xf bank_mask:0xf
    v_add_f32_dpp v13, v13, v13 row_half_mirror row_mask:0xf bank_mask:0xf
    v_add_f32_dpp v14, v14, v14 row_half_mirror row_mask:0xf bank_mask:0xf
    v_add_f32_dpp v15, v15, v15 row_half_mirror row_mask:0xf bank_mask:0xf
    v_mov_b32_sdwa v12, s68 dst_sel:BYTE_0 dst_unused:UNUSED_PRESERVE src0_sel:BYTE_0
    v_mov_b32_sdwa v13, s68 dst_sel:BYTE_0 dst_unused:UNUSED_PRESERVE src0_sel:BYTE_1
    v_mov_b32_sdwa v14, s68 dst_sel:BYTE_0 dst_unused:UNUSED_PRESERVE src0_sel:BYTE_2
    v_mov_b32_sdwa v15, s68 dst_sel:BYTE_0 dst_unused:UNUSED_PRESERVE src0_sel:BYTE_3
    s_cmp_eq_u32 s73, 0
    s_cbranch_scc0 L_ps16
    buffer_store_dwordx4 v[12:15], v26, s[60:63], s44 offen
L_pe17:
L_nopub:
    s_cmp_eq_u32 s66, 3
    s_cbranch_scc1 L_fin
    buffer_load_dwordx4 v[20:23], v27, s[60:63], s42 offen sc1
    s_mov_b32 s69, 2000000
    s_waitcnt vmcnt(5)
    v_mfma_f32_16x16x32_bf16 v[128:131], v[56:59], v[80:83], 0
L_ochk:
    s_waitcnt vmcnt(0)
    v_perm_b32 v8, v21, v20, s74
    v_perm_b32 v9, v23, v22, s74
    v_lshl_or_b32 v8, v9, 16, v8
    v_cmp_ne_u32 vcc, s68, v8
    v_and_b32 v12, s75, v20
    v_and_b32 v13, s75, v21
    v_and_b32 v14, s75, v22
    v_and_b32 v15, s75, v23
    s_cbranch_vccnz L_oretry
L_ook:
    v_add_f32_dpp v12, v12, v12 quad_perm:[1,0,3,2] row_mask:0xf bank_mask:0xf
    v_add_f32_dpp v13, v13, v13 quad_perm:[1,0,3,2] row_mask:0xf bank_mask:0xf
    v_add_f32_dpp v14, v14, v14 quad_perm:[1,0,3,2] row_mask:0xf bank_mask:0xf
    v_add_f32_dpp v15, v15, v15 quad_perm:[1,0,3,2] row_mask:0xf bank_mask:0xf
    v_add_f32_dpp v12, v12, v12 quad_perm:[2,3,0,1] row_mask:0xf bank_mask:0xf
    v_add_f32_dpp v13, v13, v13 quad_perm:[2,3,0,1] row_mask:0xf bank_mask:0xf
    v_add_f32_dpp v14, v14, v14 quad_perm:[2,3,0,1] row_mask:0xf bank_mask:0xf
    v_add_f32_dpp v15, v15, v15 quad_perm:[2,3,0,1] row_mask:0xf bank_mask:0xf
    v_add_f32_dpp v12, v12, v12 row_half_mirror row_mask:0xf bank_mask:0xf
    v_add_f32_dpp v13, v13, v13 row_half_mirror row_mask:0xf bank_mask:0xf
    v_add_f32_dpp v14, v14, v14 row_half_mirror row_mask:0xf bank_mask:0xf
    v_add_f32_dpp v15, v15, v15 row_half_mirror row_mask:0xf bank_mask:0xf
    v_cvt_pk_bf16_f32 v12, v12, v12
    v_cvt_pk_bf16_f32 v13, v13, v13
    v_cvt_pk_bf16_f32 v14, v14, v14
    v_cvt_pk_bf16_f32 v15, v15, v15
    v_and_b32 v96, v12, v2
    v_and_b32 v97, v12, v3
    v_and_b32 v98, v12, v4
    v_and_b32 v99, v12, v5
    v_and_b32 v100, v13, v2
    v_and_b32 v101, v13, v3
    v_mfma_f32_16x16x32_bf16 v[128:131], v[96:99], v[64:67], v[128:131]
    v_and_b32 v102, v13, v4
    v_and_b32 v103, v13, v5
    v_and_b32 v104, v14, v2
    v_and_b32 v105, v14, v3
    v_mfma_f32_16x16x32_bf16 v[128:131], v[100:103], v[68:71], v[128:131]
    v_and_b32 v106, v14, v4
    v_and_b32 v107, v14, v5
    v_and_b32 v108, v15, v2
    v_and_b32 v109, v15, v3
    v_mfma_f32_16x16x32_bf16 v[128:131], v[104:107], v[72:75], v[128:131]
    v_and_b32 v110, v15, v4
    v_and_b32 v111, v15, v5
    s_cmp_lg_u32 s3, 0
    s_nop 0
    v_mfma_f32_16x16x32_bf16 v[128:131], v[108:111], v[76:79], v[128:131]
    s_cmp_lg_u32 s3, 0
    s_nop 6
    v_permlane32_swap_b32 v128, v129
    v_permlane32_swap_b32 v130, v131
    s_nop 0
    v_add_f32_dpp v8, v129, v128 row_ror:8 row_mask:0xf bank_mask:0x3
    s_nop 1
    v_add_f32_dpp v8, v130, v131 row_ror:8 row_mask:0xf bank_mask:0xc
    ds_write_b32 v29, v8 offset:8704
    s_waitcnt lgkmcnt(0)
    s_barrier
    s_cbranch_scc1 L_done
    ds_read_b128 v[8:11], v30 offset:8704
    ds_read_b128 v[12:15], v30 offset:10240
    s_waitcnt lgkmcnt(0)
    v_add_f32 v8, v8, v12
    v_add_f32 v9, v9, v13
    v_add_f32 v10, v10, v14
    v_add_f32 v11, v11, v15
    v_add_f32_dpp v8, v8, v8 row_ror:4 row_mask:0xf bank_mask:0xf
    v_add_f32_dpp v9, v9, v9 row_ror:4 row_mask:0xf bank_mask:0xf
    v_add_f32_dpp v10, v10, v10 row_ror:4 row_mask:0xf bank_mask:0xf
    v_add_f32_dpp v11, v11, v11 row_ror:4 row_mask:0xf bank_mask:0xf
    v_add_f32_dpp v8, v8, v8 row_ror:8 row_mask:0xf bank_mask:0xf
    v_add_f32_dpp v9, v9, v9 row_ror:8 row_mask:0xf bank_mask:0xf
    v_add_f32_dpp v10, v10, v10 row_ror:8 row_mask:0xf bank_mask:0xf
    v_add_f32_dpp v11, v11, v11 row_ror:8 row_mask:0xf bank_mask:0xf
    v_mov_b32_sdwa v8, s68 dst_sel:BYTE_0 dst_unused:UNUSED_PRESERVE src0_sel:BYTE_0
    v_mov_b32_sdwa v9, s68 dst_sel:BYTE_0 dst_unused:UNUSED_PRESERVE src0_sel:BYTE_1
    v_mov_b32_sdwa v10, s68 dst_sel:BYTE_0 dst_unused:UNUSED_PRESERVE src0_sel:BYTE_2
    v_mov_b32_sdwa v11, s68 dst_sel:BYTE_0 dst_unused:UNUSED_PRESERVE src0_sel:BYTE_3
    s_nop 0
    buffer_store_dwordx4 v[8:11], v31, s[60:63], s45 offen sc1
    s_endpgm
L_oretry:
    buffer_load_dwordx4 v[20:23], v27, s[60:63], s42 offen sc1
    s_sub_u32 s69, s69, 1
    s_cbranch_scc0 L_ochk
    s_branch L_ook
L_fin:
    s_and_b32 s70, s64, 3
    s_lshr_b32 s71, s3, 2
    s_mul_i32 s70, s70, s71
    s_cmp_lg_u32 s70, 0
    s_cbranch_scc1 L_done
    s_lshr_b32 s70, s64, 2
    s_add_u32 s70, s70, 8
    s_cmp_eq_u32 s71, 0
    s_cselect_b32 s70, s64, s70
    s_lshl1_add_u32 s70, s70, s67
    s_and_b32 s71, s3, 3
    s_lshl2_add_u32 s70, s70, s71
    s_lshr_b32 s72, s70, 1
    s_and_b32 s69, s70, 1
    s_and_b32 s71, s72, 62
    s_add_u32 s71, s71, s72
    s_lshl_b32 s71, s71, 12
    s_add_u32 s71, s71, 524288
    s_and_b32 s25, s24, 0x55555555
    s_bcnt1_i32_b32 s25, s25
    s_and_b32 s26, s24, 0xaaaaaaaa
    s_bcnt1_i32_b32 s26, s26
    s_cmp_gt_u32 s26, s25
    s_cselect_b32 s26, 0x2000, 0
    s_add_u32 s71, s71, s26
    s_lshl_b32 s46, s69, 5
    s_add_u32 s71, s71, s46
    s_lshr_b32 s46, s72, 2
    s_lshl_b32 s46, s46, 6
    s_lshl1_add_u32 s46, s69, s46
    s_and_b32 s69, s72, 1
    s_lshl2_add_u32 s46, s69, s46
    s_bfe_u32 s69, s72, 0x10001
    s_add_u32 s46, s46, s69
    s_lshl_b32 s46, s46, 1
    v_lshrrev_b32 v8, 5, v0
    v_bfe_u32 v9, v0, 2, 2
    v_and_b32 v27, 31, v0
    v_lshlrev_b32 v27, 7, v27
    v_lshl_add_u32 v27, v8, 4, v27
    v_lshl_add_u32 v8, v8, 2, v9
    v_lshlrev_b32 v8, 4, v8
    buffer_load_ushort v61, v8, s[28:31], s46 offen
    v_and_b32 v10, 19, v0
    v_mov_b32 v11, 0x40000000
    v_cmp_eq_u32 vcc, 0, v10
    s_nop 1
    v_cndmask_b32 v9, v11, v8, vcc
    v_mov_b32 v20, 0
    v_mov_b32 v21, 0
    v_mov_b32 v22, 0
    v_mov_b32 v23, 0
    s_mov_b32 s69, 2000000
    s_mov_b32 exec_lo, 0xffffff
    s_mov_b32 exec_hi, 0xffffff
L_fchk:
    buffer_load_dwordx4 v[20:23], v27, s[60:63], s71 offen sc1
    s_sub_u32 s69, s69, 1
    s_cbranch_scc1 L_fok
    s_waitcnt vmcnt(0)
    v_perm_b32 v10, v21, v20, s74
    v_perm_b32 v11, v23, v22, s74
    v_lshl_or_b32 v10, v11, 16, v10
    v_cmp_ne_u32 vcc, s68, v10
    s_nop 0
    s_and_b64 exec, exec, vcc
    s_cbranch_scc1 L_fchk
L_fok:
    s_mov_b64 exec, -1
    v_and_b32 v20, s75, v20
    v_and_b32 v21, s75, v21
    v_and_b32 v22, s75, v22
    v_and_b32 v23, s75, v23
    v_add_f32_dpp v12, v20, v20 row_ror:8 row_mask:0xf bank_mask:0x3
    v_add_f32_dpp v13, v21, v21 row_ror:8 row_mask:0xf bank_mask:0x3
    v_lshlrev_b32 v61, 16, v61
    v_add_f32_dpp v12, v22, v22 row_ror:8 row_mask:0xf bank_mask:0xc
    v_add_f32_dpp v13, v23, v23 row_ror:8 row_mask:0xf bank_mask:0xc
    s_nop 0
    v_add_f32_dpp v14, v12, v12 row_half_mirror row_mask:0xf bank_mask:0x5
    s_nop 1
    v_add_f32_dpp v14, v13, v13 row_half_mirror row_mask:0xf bank_mask:0xa
    s_nop 1
    v_add_f32_dpp v14, v14, v14 quad_perm:[1,0,3,2] row_mask:0xf bank_mask:0xf
    s_nop 1
    v_add_f32_dpp v14, v14, v14 quad_perm:[2,3,0,1] row_mask:0xf bank_mask:0xf
    v_add_f32 v61, v61, v14
    s_nop 0
    v_permlane16_swap_b32 v14, v12
    v_add_f32 v61, v61, v12
    v_cvt_pk_bf16_f32 v61, v61, v61
    buffer_store_short v61, v9, s[56:59], s46 offen
    s_cmp_lg_u32 s70, 0
    s_cbranch_scc1 L_done
    v_mov_b32 v10, s68
    v_mov_b32 v11, 0
    s_mov_b64 exec, 1
    buffer_store_dword v10, v11, s[60:63], 0 offen
    s_mov_b64 exec, -1
L_done:
    s_endpgm
L_ps5:
    s_nop 1
    buffer_store_dwordx4 v[56:59], v9, s[60:63], s0 offen sc1
    s_branch L_pe6
L_gretry:
    s_nop 1
    s_sub_u32 s69, s69, 1
    s_cbranch_scc1 L_gok
    buffer_load_dwordx4 v[240:243], v10, s[60:63], s1 offen offset:0 sc1
    buffer_load_dwordx4 v[244:247], v10, s[60:63], s1 offen offset:1024 sc1
    buffer_load_dwordx4 v[248:251], v60, s[60:63], s1 offen offset:2048 sc1
    s_waitcnt vmcnt(0)
    s_branch L_gchk
L_ps14:
    s_nop 1
    buffer_store_dwordx3 v[16:18], v9, s[60:63], s70 offen sc1
    s_branch L_pe15
L_stretry:
    s_nop 1
    s_sub_u32 s69, s69, 1
    s_cbranch_scc1 L_stok
    buffer_load_dwordx3 v[32:34], v28, s[60:63], s43 offen sc1
    s_waitcnt vmcnt(0)
    s_branch L_stchk
L_ps16:
    s_nop 1
    buffer_store_dwordx4 v[12:15], v26, s[60:63], s44 offen sc1
    s_branch L_pe17
L_end:
    s_endpgm
.section .rodata,"a"
.p2align 6
.amdhsa_kernel parallel_sum__gqa_block_cached__glu_gated_swiglu__decode_kernel
  .amdhsa_next_free_vgpr 256
  .amdhsa_next_free_sgpr 96
  .amdhsa_accum_offset 256
  .amdhsa_group_segment_fixed_size 0
  .amdhsa_kernarg_size 96
  .amdhsa_user_sgpr_count 2
  .amdhsa_user_sgpr_kernarg_segment_ptr 1
  .amdhsa_system_sgpr_workgroup_id_x 1
  .amdhsa_float_denorm_mode_32 3
.end_amdhsa_kernel
```
